```python
import torch

def _softmax(x, axis=-1):
    return torch.softmax(x, dim=axis)
def _gelu(x):
    return torch.nn.functional.gelu(x, approximate="tanh")
def _silu(x):
    return torch.nn.functional.silu(x)
def _sigmoid(x):
    return torch.sigmoid(x)
def _layernorm(x, axis=-1, eps=1e-5):
    m = x.mean(dim=axis, keepdim=True)
    v = x.var(dim=axis, keepdim=True, unbiased=False)
    return (x - m) / torch.sqrt(v + eps)
def _scatter_add(tgt, idx, src, axis=0):
    return tgt.clone().index_add_(axis, idx, src)
def _segment_sum(src, seg, n):
    out = torch.zeros((n,) + src.shape[1:], dtype=src.dtype)
    return out.index_add_(0, seg, src)
def _pad(x, pw):
    flat = tuple(v for pair in reversed(pw) for v in pair)
    return torch.nn.functional.pad(x, flat)

kernel_name = 'standalone__deepnorm__sampling'

def setup_inputs():

    _w = (lambda a: (lambda t: t.to(torch.bfloat16) if t.is_floating_point() else t)(torch.as_tensor(a)))
    B, S, D = 1024, 4, 1024
    return {
        "x": _w((lambda *s: torch.randn(*s, dtype=torch.bfloat16) * 0.05)(B, S, D)),
        "f": _w((lambda *s: torch.randn(*s, dtype=torch.bfloat16) * 0.05)(B, S, D)),
        "g": _w((lambda *s: torch.randn(*s, dtype=torch.bfloat16) * 0.05)(D) + 1.0),
        "b": _w((lambda *s: torch.randn(*s, dtype=torch.bfloat16) * 0.4)(D)),
        "alpha": _w(float(2.0)),
    }

def reference(x, f, g, b, alpha):
    return _layernorm(alpha * x + f, axis=-1) * g + b
```

```asm
; @launch grid=(256,1,1) block=(512,1,1) lds=0
.amdgcn_target "amdgcn-amd-amdhsa--gfx950"
.text
.globl standalone__deepnorm__sampling_kernel
.p2align 12
.p2align 8
.type standalone__deepnorm__sampling_kernel,@function
standalone__deepnorm__sampling_kernel:
    s_load_dwordx16 s[4:19], s[0:1], 0
    s_cmpk_ge_u32 s2, 0x100
    s_cbranch_scc1 L_end
    v_and_b32 v2, 63, v0
    v_lshlrev_b32 v2, 4, v2
    v_lshrrev_b32 v1, 6, v0
    v_lshl_add_u32 v1, v1, 11, v2
    v_lshl_add_u32 v1, s2, 14, v1
    v_add_u32 v7, 0x400000, v1
    s_mov_b32 s20, 0xffff0000
    s_movk_i32 s24, 0x3f80
    v_mov_b32 v6, 0x38a7c5ac
    s_waitcnt lgkmcnt(0)
    s_load_dword s21, s[12:13], 0
    global_load_dwordx4 v[24:27], v1, s[6:7] offset:0 nt
    global_load_dwordx4 v[16:19], v1, s[4:5] offset:0 nt
    global_load_dwordx4 v[28:31], v1, s[6:7] offset:1024 nt
    global_load_dwordx4 v[20:23], v1, s[4:5] offset:1024 nt
    global_load_dwordx4 v[40:43], v2, s[8:9] offset:0
    global_load_dwordx4 v[44:47], v2, s[8:9] offset:1024
    global_load_dwordx4 v[48:51], v2, s[10:11] offset:0
    global_load_dwordx4 v[52:55], v2, s[10:11] offset:1024
    s_waitcnt lgkmcnt(0)
    s_pack_ll_b32_b16 s22, s21, 0
    s_pack_ll_b32_b16 s23, 0, s21
    s_pack_lh_b32_b16 s25, s21, 1.0
    v_mov_b32 v5, s25
L_loop:
    s_waitcnt vmcnt(4)
    v_readfirstlane_b32 s25, v16
    v_readfirstlane_b32 s26, v24
    s_pack_ll_b32_b16 s25, s25, s26
    v_dot2_f32_bf16 v4, s25, v5, 0 neg_lo:[1,0,0] neg_hi:[1,0,0]
    v_dot2_f32_bf16 v88, v24, s24, v4
    v_dot2_f32_bf16 v89, v24, 1.0, v4
    v_dot2_f32_bf16 v90, v25, s24, v4
    v_dot2_f32_bf16 v91, v25, 1.0, v4
    v_dot2_f32_bf16 v92, v26, s24, v4
    v_dot2_f32_bf16 v93, v26, 1.0, v4
    v_dot2_f32_bf16 v94, v27, s24, v4
    v_dot2_f32_bf16 v95, v27, 1.0, v4
    v_dot2c_f32_bf16 v88, s22, v16
    v_dot2c_f32_bf16 v89, s23, v16
    v_dot2c_f32_bf16 v90, s22, v17
    v_dot2c_f32_bf16 v91, s23, v17
    v_dot2c_f32_bf16 v92, s22, v18
    v_dot2c_f32_bf16 v93, s23, v18
    v_dot2c_f32_bf16 v94, s22, v19
    v_dot2c_f32_bf16 v95, s23, v19
    s_waitcnt vmcnt(3)
    v_dot2_f32_bf16 v96, v28, s24, v4
    v_dot2_f32_bf16 v97, v28, 1.0, v4
    v_dot2_f32_bf16 v98, v29, s24, v4
    v_dot2_f32_bf16 v99, v29, 1.0, v4
    v_dot2_f32_bf16 v100, v30, s24, v4
    v_dot2_f32_bf16 v101, v30, 1.0, v4
    v_dot2_f32_bf16 v102, v31, s24, v4
    v_dot2_f32_bf16 v103, v31, 1.0, v4
    s_waitcnt vmcnt(2)
    v_dot2c_f32_bf16 v96, s22, v20
    v_dot2c_f32_bf16 v97, s23, v20
    v_dot2c_f32_bf16 v98, s22, v21
    v_dot2c_f32_bf16 v99, s23, v21
    v_dot2c_f32_bf16 v100, s22, v22
    v_dot2c_f32_bf16 v101, s23, v22
    v_dot2c_f32_bf16 v102, s22, v23
    v_dot2c_f32_bf16 v103, s23, v23
    s_cbranch_scc1 L_skip
    global_load_dwordx4 v[24:27], v7, s[6:7] offset:0 nt
    global_load_dwordx4 v[16:19], v7, s[4:5] offset:0 nt
    global_load_dwordx4 v[28:31], v7, s[6:7] offset:1024 nt
    global_load_dwordx4 v[20:23], v7, s[4:5] offset:1024 nt
    s_waitcnt vmcnt(4)
    v_lshlrev_b32 v56, 16, v40
    v_and_b32 v57, s20, v40
    v_lshlrev_b32 v58, 16, v41
    v_and_b32 v59, s20, v41
    v_lshlrev_b32 v60, 16, v42
    v_and_b32 v61, s20, v42
    v_lshlrev_b32 v62, 16, v43
    v_and_b32 v63, s20, v43
    v_lshlrev_b32 v64, 16, v44
    v_and_b32 v65, s20, v44
    v_lshlrev_b32 v66, 16, v45
    v_and_b32 v67, s20, v45
    v_lshlrev_b32 v68, 16, v46
    v_and_b32 v69, s20, v46
    v_lshlrev_b32 v70, 16, v47
    v_and_b32 v71, s20, v47
    v_lshlrev_b32 v72, 16, v48
    v_and_b32 v73, s20, v48
    v_lshlrev_b32 v74, 16, v49
    v_and_b32 v75, s20, v49
    v_lshlrev_b32 v76, 16, v50
    v_and_b32 v77, s20, v50
    v_lshlrev_b32 v78, 16, v51
    v_and_b32 v79, s20, v51
    v_lshlrev_b32 v80, 16, v52
    v_and_b32 v81, s20, v52
    v_lshlrev_b32 v82, 16, v53
    v_and_b32 v83, s20, v53
    v_lshlrev_b32 v84, 16, v54
    v_and_b32 v85, s20, v54
    v_lshlrev_b32 v86, 16, v55
    v_and_b32 v87, s20, v55
L_skip:
    v_pk_fma_f32 v[10:11], v[88:89], v[88:89], v[6:7] op_sel_hi:[1,1,0]
    v_pk_fma_f32 v[10:11], v[90:91], v[90:91], v[10:11]
    v_pk_add_f32 v[8:9], v[88:89], v[90:91]
    v_pk_fma_f32 v[10:11], v[92:93], v[92:93], v[10:11]
    v_pk_add_f32 v[8:9], v[8:9], v[92:93]
    v_pk_fma_f32 v[10:11], v[94:95], v[94:95], v[10:11]
    v_pk_add_f32 v[8:9], v[8:9], v[94:95]
    v_pk_fma_f32 v[10:11], v[96:97], v[96:97], v[10:11]
    v_pk_add_f32 v[8:9], v[8:9], v[96:97]
    v_pk_fma_f32 v[10:11], v[98:99], v[98:99], v[10:11]
    v_pk_add_f32 v[8:9], v[8:9], v[98:99]
    v_pk_fma_f32 v[10:11], v[100:101], v[100:101], v[10:11]
    v_pk_add_f32 v[8:9], v[8:9], v[100:101]
    v_pk_fma_f32 v[10:11], v[102:103], v[102:103], v[10:11]
    v_pk_add_f32 v[8:9], v[8:9], v[102:103]
    v_add_f32 v8, v8, v9
    v_add_f32 v10, v10, v11
    s_nop 1
    v_permlane32_swap_b32 v8, v10
    v_add_f32 v8, v8, v10
    v_mul_f32 v8, 0x3a800000, v8
    s_nop 1
    v_add_f32_dpp v8, v8, v8 quad_perm:[1,0,3,2] row_mask:0xf bank_mask:0xf
    s_nop 1
    v_add_f32_dpp v8, v8, v8 quad_perm:[2,3,0,1] row_mask:0xf bank_mask:0xf
    s_nop 1
    v_add_f32_dpp v8, v8, v8 row_half_mirror row_mask:0xf bank_mask:0xf
    s_nop 1
    v_add_f32_dpp v8, v8, v8 row_mirror row_mask:0xf bank_mask:0xf
    s_nop 1
    v_add_f32_dpp v8, v8, v8 row_bcast:15 row_mask:0xa bank_mask:0xf
    s_nop 0
    v_readlane_b32 s28, v8, 31
    v_readlane_b32 s30, v8, 63
    s_nop 0
    v_mul_f32_e64 v12, s28, s28
    v_sub_f32 v12, s30, v12
    v_rsq_f32 v12, v12
    s_nop 0
    v_mul_f32_e64 v13, -s28, v12
    v_pk_fma_f32 v[88:89], v[88:89], v[12:13], v[12:13] op_sel:[0,0,1] op_sel_hi:[1,0,1]
    v_pk_fma_f32 v[88:89], v[88:89], v[56:57], v[72:73]
    v_cvt_pk_bf16_f32 v32, v88, v89
    v_pk_fma_f32 v[90:91], v[90:91], v[12:13], v[12:13] op_sel:[0,0,1] op_sel_hi:[1,0,1]
    v_pk_fma_f32 v[90:91], v[90:91], v[58:59], v[74:75]
    v_cvt_pk_bf16_f32 v33, v90, v91
    v_pk_fma_f32 v[92:93], v[92:93], v[12:13], v[12:13] op_sel:[0,0,1] op_sel_hi:[1,0,1]
    v_pk_fma_f32 v[92:93], v[92:93], v[60:61], v[76:77]
    v_cvt_pk_bf16_f32 v34, v92, v93
    v_pk_fma_f32 v[94:95], v[94:95], v[12:13], v[12:13] op_sel:[0,0,1] op_sel_hi:[1,0,1]
    v_pk_fma_f32 v[94:95], v[94:95], v[62:63], v[78:79]
    v_cvt_pk_bf16_f32 v35, v94, v95
    global_store_dwordx4 v1, v[32:35], s[14:15] offset:0
    v_pk_fma_f32 v[96:97], v[96:97], v[12:13], v[12:13] op_sel:[0,0,1] op_sel_hi:[1,0,1]
    v_pk_fma_f32 v[96:97], v[96:97], v[64:65], v[80:81]
    v_cvt_pk_bf16_f32 v36, v96, v97
    v_pk_fma_f32 v[98:99], v[98:99], v[12:13], v[12:13] op_sel:[0,0,1] op_sel_hi:[1,0,1]
    v_pk_fma_f32 v[98:99], v[98:99], v[66:67], v[82:83]
    v_cvt_pk_bf16_f32 v37, v98, v99
    v_pk_fma_f32 v[100:101], v[100:101], v[12:13], v[12:13] op_sel:[0,0,1] op_sel_hi:[1,0,1]
    v_pk_fma_f32 v[100:101], v[100:101], v[68:69], v[84:85]
    v_cvt_pk_bf16_f32 v38, v100, v101
    v_pk_fma_f32 v[102:103], v[102:103], v[12:13], v[12:13] op_sel:[0,0,1] op_sel_hi:[1,0,1]
    v_pk_fma_f32 v[102:103], v[102:103], v[70:71], v[86:87]
    v_cvt_pk_bf16_f32 v39, v102, v103
    global_store_dwordx4 v1, v[36:39], s[14:15] offset:1024
    s_cbranch_scc1 L_end
    s_cmp_eq_u32 0, 0
    v_mov_b32 v1, v7
    s_branch L_loop
L_end:
    s_endpgm
.section .rodata,"a"
.p2align 6
.amdhsa_kernel standalone__deepnorm__sampling_kernel
  .amdhsa_next_free_vgpr 104
  .amdhsa_next_free_sgpr 32
  .amdhsa_accum_offset 104
  .amdhsa_group_segment_fixed_size 0
  .amdhsa_kernarg_size 64
  .amdhsa_user_sgpr_count 2
  .amdhsa_user_sgpr_kernarg_segment_ptr 1
  .amdhsa_system_sgpr_workgroup_id_x 1
  .amdhsa_float_denorm_mode_32 3
.end_amdhsa_kernel
```
